```python
import torch

def _softmax(x, axis=-1):
    return torch.softmax(x, dim=axis)
def _gelu(x):
    return torch.nn.functional.gelu(x, approximate="tanh")
def _silu(x):
    return torch.nn.functional.silu(x)
def _sigmoid(x):
    return torch.sigmoid(x)
def _layernorm(x, axis=-1, eps=1e-5):
    m = x.mean(dim=axis, keepdim=True)
    v = x.var(dim=axis, keepdim=True, unbiased=False)
    return (x - m) / torch.sqrt(v + eps)
def _scatter_add(tgt, idx, src, axis=0):
    return tgt.clone().index_add_(axis, idx, src)
def _segment_sum(src, seg, n):
    out = torch.zeros((n,) + src.shape[1:], dtype=src.dtype)
    return out.index_add_(0, seg, src)
def _pad(x, pw):
    flat = tuple(v for pair in reversed(pw) for v in pair)
    return torch.nn.functional.pad(x, flat)

kernel_name = 'standalone__rmsnorm__sampling'

def setup_inputs():

    _w = (lambda a: (lambda t: t.to(torch.bfloat16) if t.is_floating_point() else t)(torch.as_tensor(a)))
    B, S, D = 1024, 32, 512
    return {
        "x": _w((lambda *s: torch.randn(*s, dtype=torch.bfloat16) * 0.05)(B, S, D)),
        "g": _w((lambda *s: torch.randn(*s, dtype=torch.bfloat16) * 0.05)(D) + 1.0),
    }

def reference(x, g):
    rms = torch.sqrt((x * x).mean(axis=-1, keepdims=True) + 1e-6)
    return x / rms * g
```

```asm
; @launch grid=(256,1,1) block=(512,1,1) lds=0
.amdgcn_target "amdgcn-amd-amdhsa--gfx950"
.text
.globl standalone__rmsnorm__sampling_kernel
.p2align 12
.p2align 8
.type standalone__rmsnorm__sampling_kernel,@function
standalone__rmsnorm__sampling_kernel:
    s_load_dwordx4 s[4:7], s[0:1], 0
    s_load_dwordx4 s[12:15], s[0:1], 16
    v_readfirstlane_b32 s3, v0
    s_getreg_b32 s18, hwreg(HW_REG_XCC_ID, 0, 3)
    s_lshr_b32 s26, s2, 3
    s_lshl_b32 s22, s2, 13
    s_xor_b32 s23, s22, 0x2400
    s_or_b32 s26, s26, s3
    s_cbranch_scc1 L_probed
L_probe:
    s_memtime s[34:35]
    s_waitcnt lgkmcnt(0)
    s_and_b32 s34, s34, 0x7c
    s_lshl_b32 s34, s34, 14
    s_add_u32 s16, s4, 29360128
    s_addc_u32 s17, s5, 0
    s_or_b32 s22, s22, s34
    s_or_b32 s23, s23, s34
    s_load_dword s32, s[16:17], s22 glc
    s_load_dword s33, s[16:17], s23 glc
    s_mov_b32 s28, 2
    s_waitcnt lgkmcnt(1)
L_gap:
    s_getreg_b32 s19, hwreg(HW_REG_IB_STS, 8, 4)
    s_cmp_eq_u32 s19, 0
    s_cbranch_scc1 L_nogap
    s_sub_u32 s28, s28, 1
    s_cbranch_scc0 L_gap
    s_sub_u32 s19, s18, s2
    s_and_b32 s19, s19, 7
    s_lshl_b32 s18, s18, 1
    s_lshr_b32 s23, s22, 10
    s_xor_b32 s18, s18, s23
    s_and_b32 s18, s18, 8
    s_or_b32 s19, s19, s18
    v_or_b32 v2, 16, s19
    v_mov_b32 v3, 0
    s_mov_b64 exec, 1
    global_atomic_cmpswap v3, v[2:3], s[14:15] sc1
    s_mov_b64 exec, -1
L_nogap:
L_probed:
    s_lshr_b32 s20, s2, 8
    s_cbranch_scc1 L_end
    s_lshr_b32 s3, s3, 6
    v_bfe_u32 v1, v0, 5, 1
    v_and_b32 v0, 31, v0
    v_lshlrev_b32 v0, 4, v0
    v_lshl_or_b32 v1, v1, 10, v0
    s_lshr_b32 s20, s2, 3
    s_and_b32 s22, s2, 3
    s_lshl2_add_u32 s20, s20, s22
    s_lshl3_add_u32 s20, s20, s3
    s_and_b32 s22, s20, 3
    s_lshl_b32 s22, s22, 11
    s_lshr_b32 s20, s20, 2
    s_lshl_b32 s20, s20, 14
    s_or_b32 s20, s20, s22
    s_lshl_b32 s21, s2, 11
    s_and_b32 s21, s21, 0x2000
    s_or_b32 s21, s21, s20
    v_add_u32 v2, s21, v1
    s_mov_b32 s10, 0x2000000
    s_mov_b32 s11, 0x20000
    s_waitcnt lgkmcnt(0)
    s_mov_b32 s8, s4
    s_mov_b32 s9, s5
    global_load_dwordx4 v[52:55], v0, s[6:7] offset:0
    global_load_dwordx4 v[56:59], v0, s[6:7] offset:512
    buffer_load_dwordx4 v[4:7], v2, s[8:11], 0 offen offset:0 nt
    buffer_load_dwordx4 v[8:11], v2, s[8:11], 0 offen offset:512 nt
    v_add_u32 v2, 4194304, v2
    v_add_u32 v3, s21, v1
    s_and_b32 s22, s2, 7
    s_lshr_b32 s22, 0xf0f0, s22
    s_and_b32 s22, s22, 0xff
    s_mul_i32 s22, s22, 0x1010000
    s_lshr_b32 s23, s21, 8
    s_xor_b32 s23, s23, s21
    s_bitcmp1_b32 s23, 13
    s_mov_b32 s23, 0xff000000
    s_cselect_b32 s23, 0xff0000, s23
    s_xor_b32 s28, s22, s23
    s_mov_b32 s24, 0xffff0000
    s_mov_b32 s29, 0
    s_mov_b32 s30, s14
    s_mov_b32 s31, s15
    v_mov_b32 v1, 0
    s_mov_b32 s14, 0x2000000
    s_mov_b32 s15, 0x20000
    s_mov_b32 s25, 4
    s_cmp_ge_u32 s3, 4
    s_cselect_b32 s36, 4, 0
    s_cselect_b32 s37, 0, 4
    s_waitcnt vmcnt(2)
    v_lshlrev_b32 v20, 16, v52
    v_and_b32 v21, s24, v52
    v_lshlrev_b32 v22, 16, v53
    v_and_b32 v23, s24, v53
    v_lshlrev_b32 v24, 16, v54
    v_and_b32 v25, s24, v54
    v_lshlrev_b32 v26, 16, v55
    v_and_b32 v27, s24, v55
    v_lshlrev_b32 v28, 16, v56
    v_and_b32 v29, s24, v56
    v_lshlrev_b32 v30, 16, v57
    v_and_b32 v31, s24, v57
    v_lshlrev_b32 v32, 16, v58
    v_and_b32 v33, s24, v58
    v_lshlrev_b32 v34, 16, v59
    v_and_b32 v35, s24, v59
    s_waitcnt vmcnt(0)
L_loop:
    buffer_load_dwordx4 v[12:15], v2, s[8:11], 0 offen offset:0 nt
    buffer_load_dwordx4 v[16:19], v2, s[8:11], 0 offen offset:512 nt
    v_add_u32 v2, 4194304, v2
    v_dot2_f32_bf16 v60, v4, v4, 0
    v_lshlrev_b32 v36, 16, v4
    v_dot2_f32_bf16 v60, v5, v5, v60
    v_and_b32 v37, s24, v4
    v_dot2_f32_bf16 v60, v6, v6, v60
    v_lshlrev_b32 v38, 16, v5
    v_dot2_f32_bf16 v60, v7, v7, v60
    v_and_b32 v39, s24, v5
    v_dot2_f32_bf16 v60, v8, v8, v60
    v_lshlrev_b32 v40, 16, v6
    v_dot2_f32_bf16 v60, v9, v9, v60
    v_and_b32 v41, s24, v6
    v_dot2_f32_bf16 v60, v10, v10, v60
    v_lshlrev_b32 v42, 16, v7
    v_dot2_f32_bf16 v60, v11, v11, v60
    v_and_b32 v43, s24, v7
    v_lshlrev_b32 v44, 16, v8
    v_and_b32 v45, s24, v8
    v_add_f32_dpp v60, v60, v60 row_ror:8 row_mask:0xf bank_mask:0xf
    v_lshlrev_b32 v46, 16, v9
    v_and_b32 v47, s24, v9
    v_add_f32_dpp v60, v60, v60 row_ror:4 row_mask:0xf bank_mask:0xf
    v_lshlrev_b32 v48, 16, v10
    v_and_b32 v49, s24, v10
    v_add_f32_dpp v60, v60, v60 row_ror:2 row_mask:0xf bank_mask:0xf
    v_lshlrev_b32 v50, 16, v11
    v_and_b32 v51, s24, v11
    v_add_f32_dpp v60, v60, v60 row_ror:1 row_mask:0xf bank_mask:0xf
    v_mov_b32 v61, v60
    v_pk_mul_f32 v[36:37], v[36:37], v[20:21]
    v_pk_mul_f32 v[38:39], v[38:39], v[22:23]
    v_permlane16_swap_b32 v60, v61
    v_add_f32 v60, v60, v61
    v_pk_mul_f32 v[40:41], v[40:41], v[24:25]
    v_mul_f32 v60, 0x3b000000, v60
    v_pk_mul_f32 v[42:43], v[42:43], v[26:27]
    v_cvt_pk_bf16_f32 v60, 0, v60
    v_pk_mul_f32 v[44:45], v[44:45], v[28:29]
    v_add_f32 v60, 0x358637bd, v60
    v_pk_mul_f32 v[46:47], v[46:47], v[30:31]
    v_cvt_pk_bf16_f32 v60, 0, v60
    v_sqrt_f32 v60, v60
    v_pk_mul_f32 v[48:49], v[48:49], v[32:33]
    v_cvt_pk_bf16_f32 v60, 0, v60
    v_rcp_f32 v60, v60
    v_pk_mul_f32 v[50:51], v[50:51], v[34:35]
    v_pk_mul_f32 v[36:37], v[36:37], v[60:61] op_sel_hi:[1,0]
    v_pk_mul_f32 v[38:39], v[38:39], v[60:61] op_sel_hi:[1,0]
    v_pk_mul_f32 v[40:41], v[40:41], v[60:61] op_sel_hi:[1,0]
    v_pk_mul_f32 v[42:43], v[42:43], v[60:61] op_sel_hi:[1,0]
    v_cvt_pk_bf16_f32 v52, v36, v37
    v_cvt_pk_bf16_f32 v53, v38, v39
    v_cvt_pk_bf16_f32 v54, v40, v41
    v_cvt_pk_bf16_f32 v55, v42, v43
    buffer_store_dwordx4 v[52:55], v3, s[12:15], 0 offen offset:0 sc0 sc1
    v_pk_mul_f32 v[44:45], v[44:45], v[60:61] op_sel_hi:[1,0]
    v_pk_mul_f32 v[46:47], v[46:47], v[60:61] op_sel_hi:[1,0]
    v_pk_mul_f32 v[48:49], v[48:49], v[60:61] op_sel_hi:[1,0]
    v_pk_mul_f32 v[50:51], v[50:51], v[60:61] op_sel_hi:[1,0]
    v_cvt_pk_bf16_f32 v56, v44, v45
    v_cvt_pk_bf16_f32 v57, v46, v47
    v_cvt_pk_bf16_f32 v58, v48, v49
    v_cvt_pk_bf16_f32 v59, v50, v51
    buffer_store_dwordx4 v[56:59], v3, s[12:15], 0 offen offset:512 sc0 sc1
    v_add_u32 v3, 4194304, v3
    s_cmp_lg_u32 s25, s36
    s_cbranch_scc1 L_nopr
    s_load_dword s27, s[30:31], 0
L_nopr:
    s_waitcnt vmcnt(2)
    s_cmp_lg_u32 s25, s37
    s_cbranch_scc1 L_nopr2
    s_load_dword s27, s[30:31], 0
L_nopr2:
    s_waitcnt lgkmcnt(0)
    s_cmp_eq_u32 s27, 0
    s_cbranch_scc1 L_slow
L_got:
    s_bitcmp1_b32 s28, s27
    s_cselect_b32 s29, 0x2000, 0
    s_mov_b32 s28, 0
    v_xor_b32 v2, s29, v2
    buffer_load_dwordx4 v[4:7], v2, s[8:11], 0 offen offset:0 nt
    buffer_load_dwordx4 v[8:11], v2, s[8:11], 0 offen offset:512 nt
    v_add_u32 v2, 4194304, v2
    v_dot2_f32_bf16 v60, v12, v12, 0
    v_lshlrev_b32 v36, 16, v12
    v_dot2_f32_bf16 v60, v13, v13, v60
    v_and_b32 v37, s24, v12
    v_dot2_f32_bf16 v60, v14, v14, v60
    v_lshlrev_b32 v38, 16, v13
    v_dot2_f32_bf16 v60, v15, v15, v60
    v_and_b32 v39, s24, v13
    v_dot2_f32_bf16 v60, v16, v16, v60
    v_lshlrev_b32 v40, 16, v14
    v_dot2_f32_bf16 v60, v17, v17, v60
    v_and_b32 v41, s24, v14
    v_dot2_f32_bf16 v60, v18, v18, v60
    v_lshlrev_b32 v42, 16, v15
    v_dot2_f32_bf16 v60, v19, v19, v60
    v_and_b32 v43, s24, v15
    v_lshlrev_b32 v44, 16, v16
    v_and_b32 v45, s24, v16
    v_add_f32_dpp v60, v60, v60 row_ror:8 row_mask:0xf bank_mask:0xf
    v_lshlrev_b32 v46, 16, v17
    v_and_b32 v47, s24, v17
    v_add_f32_dpp v60, v60, v60 row_ror:4 row_mask:0xf bank_mask:0xf
    v_lshlrev_b32 v48, 16, v18
    v_and_b32 v49, s24, v18
    v_add_f32_dpp v60, v60, v60 row_ror:2 row_mask:0xf bank_mask:0xf
    v_lshlrev_b32 v50, 16, v19
    v_and_b32 v51, s24, v19
    v_add_f32_dpp v60, v60, v60 row_ror:1 row_mask:0xf bank_mask:0xf
    v_mov_b32 v61, v60
    v_pk_mul_f32 v[36:37], v[36:37], v[20:21]
    v_pk_mul_f32 v[38:39], v[38:39], v[22:23]
    v_permlane16_swap_b32 v60, v61
    v_add_f32 v60, v60, v61
    v_pk_mul_f32 v[40:41], v[40:41], v[24:25]
    v_mul_f32 v60, 0x3b000000, v60
    v_pk_mul_f32 v[42:43], v[42:43], v[26:27]
    v_cvt_pk_bf16_f32 v60, 0, v60
    v_pk_mul_f32 v[44:45], v[44:45], v[28:29]
    v_add_f32 v60, 0x358637bd, v60
    v_pk_mul_f32 v[46:47], v[46:47], v[30:31]
    v_cvt_pk_bf16_f32 v60, 0, v60
    v_sqrt_f32 v60, v60
    v_pk_mul_f32 v[48:49], v[48:49], v[32:33]
    v_cvt_pk_bf16_f32 v60, 0, v60
    v_rcp_f32 v60, v60
    v_pk_mul_f32 v[50:51], v[50:51], v[34:35]
    v_pk_mul_f32 v[36:37], v[36:37], v[60:61] op_sel_hi:[1,0]
    v_pk_mul_f32 v[38:39], v[38:39], v[60:61] op_sel_hi:[1,0]
    v_pk_mul_f32 v[40:41], v[40:41], v[60:61] op_sel_hi:[1,0]
    v_pk_mul_f32 v[42:43], v[42:43], v[60:61] op_sel_hi:[1,0]
    v_cvt_pk_bf16_f32 v52, v36, v37
    v_cvt_pk_bf16_f32 v53, v38, v39
    v_cvt_pk_bf16_f32 v54, v40, v41
    v_cvt_pk_bf16_f32 v55, v42, v43
    buffer_store_dwordx4 v[52:55], v3, s[12:15], 0 offen offset:0 sc0 sc1
    v_pk_mul_f32 v[44:45], v[44:45], v[60:61] op_sel_hi:[1,0]
    v_pk_mul_f32 v[46:47], v[46:47], v[60:61] op_sel_hi:[1,0]
    v_pk_mul_f32 v[48:49], v[48:49], v[60:61] op_sel_hi:[1,0]
    v_pk_mul_f32 v[50:51], v[50:51], v[60:61] op_sel_hi:[1,0]
    v_cvt_pk_bf16_f32 v56, v44, v45
    v_cvt_pk_bf16_f32 v57, v46, v47
    v_cvt_pk_bf16_f32 v58, v48, v49
    v_cvt_pk_bf16_f32 v59, v50, v51
    buffer_store_dwordx4 v[56:59], v3, s[12:15], 0 offen offset:512 sc0 sc1
    v_add_u32 v3, 4194304, v3
    v_xor_b32 v3, s29, v3
    s_sub_u32 s25, s25, 1
    s_cmp_lg_u32 s25, 0
    s_waitcnt vmcnt(2)
    s_cbranch_scc1 L_loop
L_end:
    s_endpgm
L_slow:
    s_cmp_eq_u32 s26, 0
    s_cbranch_scc1 L_decide
    s_movk_i32 s23, 100
L_poll:
    v_mov_b32 v62, -1
    global_load_dword v62, v1, s[30:31] sc1
L_chk:
    v_readfirstlane_b32 s27, v62
    s_cmp_lt_i32 s27, 0
    s_cbranch_scc1 L_chk
    s_cmp_lg_u32 s27, 0
    s_cbranch_scc1 L_got
    s_sub_u32 s23, s23, 1
    s_cbranch_scc0 L_poll
L_decide:
    v_mov_b32 v52, 32
    v_mov_b32 v53, 0
    s_mov_b64 exec, 1
    global_atomic_cmpswap v62, v1, v[52:53], s[30:31] sc0 sc1
    s_mov_b64 exec, -1
    s_waitcnt vmcnt(0)
    v_readfirstlane_b32 s27, v62
    s_cmp_eq_u32 s27, 0
    s_cselect_b32 s27, 32, s27
    s_branch L_got
.section .rodata,"a"
.p2align 6
.amdhsa_kernel standalone__rmsnorm__sampling_kernel
  .amdhsa_next_free_vgpr 63
  .amdhsa_next_free_sgpr 40
  .amdhsa_accum_offset 64
  .amdhsa_group_segment_fixed_size 0
  .amdhsa_kernarg_size 40
  .amdhsa_user_sgpr_count 2
  .amdhsa_user_sgpr_kernarg_segment_ptr 1
  .amdhsa_system_sgpr_workgroup_id_x 1
  .amdhsa_float_denorm_mode_32 3
.end_amdhsa_kernel
```
